```python
import torch

def _softmax(x, axis=-1):
    return torch.softmax(x, dim=axis)
def _gelu(x):
    return torch.nn.functional.gelu(x, approximate="tanh")
def _silu(x):
    return torch.nn.functional.silu(x)
def _sigmoid(x):
    return torch.sigmoid(x)
def _layernorm(x, axis=-1, eps=1e-5):
    m = x.mean(dim=axis, keepdim=True)
    v = x.var(dim=axis, keepdim=True, unbiased=False)
    return (x - m) / torch.sqrt(v + eps)
def _scatter_add(tgt, idx, src, axis=0):
    return tgt.clone().index_add_(axis, idx, src)
def _segment_sum(src, seg, n):
    out = torch.zeros((n,) + src.shape[1:], dtype=src.dtype)
    return out.index_add_(0, seg, src)
def _pad(x, pw):
    flat = tuple(v for pair in reversed(pw) for v in pair)
    return torch.nn.functional.pad(x, flat)

kernel_name = 'standalone__groupnorm__prompt'

def setup_inputs():

    _w = (lambda a: (lambda t: t.to(torch.bfloat16) if t.is_floating_point() else t)(torch.as_tensor(a)))
    B = 2
    G = 32
    cpg = max(1, 1024 // G)
    C = G * cpg
    H, W = 32, 2048
    return {
        "x": _w(abs((lambda *s: torch.randn(*s, dtype=torch.bfloat16) * 0.05)(B, C, H, W))),
        "g": _w((lambda *s: torch.randn(*s, dtype=torch.bfloat16) * 0.05)(C) + 1.0),
        "b": _w((lambda *s: torch.randn(*s, dtype=torch.bfloat16) * 0.4)(C)),
    }

def reference(x, g, b):
    G = 32
    B, C, H, W = x.shape[0], x.shape[1], x.shape[2], x.shape[3]
    xr = x.reshape(B, G, C // G, H, W)
    mu = xr.mean(axis=(2, 3, 4), keepdims=True)
    var = ((xr - mu) ** 2).mean(axis=(2, 3, 4), keepdims=True)
    xn = (xr - mu) / torch.sqrt(var + 1e-5)
    xn = xn.reshape(B, C, H, W)
    return xn * g[None, :, None, None] + b[None, :, None, None]
```

```asm
; @launch grid=(256,1,1) block=(1024,1,1) lds=1648
.amdgcn_target "amdgcn-amd-amdhsa--gfx950"
.text
.globl standalone__groupnorm__prompt_kernel
.p2align 12
.p2align 8
.type standalone__groupnorm__prompt_kernel,@function
standalone__groupnorm__prompt_kernel:
    s_cmp_ge_u32 s2, 256
    s_cbranch_scc1 L_end
    s_load_dwordx2 s[16:17], s[0:1], 0
    s_load_dwordx2 s[20:21], s[0:1], 24
    s_load_dwordx4 s[12:15], s[0:1], 32
    s_load_dwordx4 s[4:7], s[0:1], 8
    s_memtime s[56:57]
    v_readfirstlane_b32 s28, v0
    v_and_b32 v22, 63, v0
    v_lshlrev_b32 v1, 4, v22
    s_mov_b32 s18, 0x10000000
    s_mov_b32 s19, 0x20000
    s_mov_b32 s22, 0x10000000
    s_mov_b32 s23, 0x20000
    s_and_b32 s29, s2, 3
    s_lshr_b32 s30, s2, 3
    s_lshl_b32 s26, s29, 22
    s_lshl_b32 s3, s30, 17
    s_add_u32 s26, s26, s3
    v_and_b32 v90, 15, v22
    v_lshlrev_b32 v90, 4, v90
    v_bfe_u32 v2, v22, 4, 1
    v_lshl_or_b32 v90, v2, 10, v90
    v_bfe_u32 v2, v22, 5, 1
    v_lshl_or_b32 v90, v2, 15, v90
    s_bitcmp1_b32 s2, 2
    s_cselect_b32 s39, 25, 6
    s_or_b32 s36, s26, s39
    s_mov_b32 s50, s36
    s_lshr_b32 s28, s28, 6
    s_mov_b32 s9, 0
    s_bitcmp1_b32 s28, 0
    s_cselect_b32 s3, 512, 0
    s_or_b32 s9, s9, s3
    s_bitcmp1_b32 s28, 1
    s_cselect_b32 s3, 4096, 0
    s_or_b32 s9, s9, s3
    s_bitcmp1_b32 s28, 2
    s_cselect_b32 s3, 256, 0
    s_or_b32 s9, s9, s3
    s_bitcmp1_b32 s28, 3
    s_cselect_b32 s3, 16384, 0
    s_or_b32 s9, s9, s3
    s_or_b32 s26, s26, s9
    s_and_b32 s3, s26, 13107200
    s_bcnt1_i32_b32 s3, s3
    s_bitcmp1_b32 s3, 0
    s_cselect_b32 s3, 2048, 0
    s_xor_b32 s26, s26, s3
    s_or_b32 s25, s26, 0x2000
    s_lshl_b32 s35, s30, 12
    s_and_b32 s35, s35, 0x2000
    s_add_u32 s35, s35, 0x4000000
    s_cmp_lg_u32 s28, 0
    s_waitcnt lgkmcnt(0)
    s_cbranch_scc1 L_noprobe
    s_lshl_b32 s3, s2, 20
    s_add_u32 s3, s56, s3
    s_mul_i32 s3, s3, 0x9e3779b1
    s_lshr_b32 s3, s3, 5
    s_and_b32 s3, s3, 0x1fdf80
    s_add_u32 s35, s35, s3
    s_xor_b32 s34, s35, 0x2000
    s_mov_b64 exec, 1
    s_bitcmp1_b32 s30, 2
    s_cbranch_scc1 L_po
    buffer_load_dword v10, v1, s[16:19], s35 offen nt
    buffer_load_dword v10, v1, s[16:19], s34 offen nt
    s_branch L_pd
L_po:
    buffer_load_dword v10, v1, s[20:23], s35 offen nt
    buffer_load_dword v10, v1, s[20:23], s34 offen nt
L_pd:
    s_mov_b64 exec, -1
    s_barrier
    s_waitcnt vmcnt(1)
    s_memtime s[58:59]
    s_waitcnt vmcnt(0)
    s_memtime s[56:57]
    s_branch L_pgo
L_noprobe:
    s_barrier
L_pgo:
    v_mov_b32 v4, -1
    v_mov_b32 v5, -1
    s_cmp_lg_u32 s28, 2
    s_cbranch_scc1 L_noown
    s_lshr_b32 s3, s2, 2
    s_cmp_ge_u32 s3, 52
    s_cbranch_scc1 L_noown
    s_and_b32 s34, s3, 3
    s_andn2_b32 s3, s3, 3
    s_add_u32 s3, s3, 12
    s_add_u32 s3, s3, s29
    s_lshl_b32 s3, s3, 2
    s_add_u32 s3, s3, s34
    s_lshl_b32 s3, s3, 7
    v_lshrrev_b32 v2, 1, v1
    v_add_u32 v2, s3, v2
    s_mov_b64 exec, 0xffff
    global_store_dwordx2 v2, v[4:5], s[14:15] sc0 sc1
    s_mov_b64 exec, -1
L_noown:
    s_lshl_b32 s3, s2, 4
    s_add_u32 s3, s3, s28
    s_cmp_lg_u32 s3, 1
    s_cbranch_scc1 L_noinit
    v_mov_b32 v6, -1
    v_mov_b32 v7, -1
    v_add_u32 v2, 0x1000, v1
    global_store_dwordx4 v1, v[4:7], s[14:15] sc0 sc1
    global_store_dwordx4 v1, v[4:7], s[14:15] offset:1024 sc0 sc1
    global_store_dwordx4 v1, v[4:7], s[14:15] offset:2048 sc0 sc1
    global_store_dwordx4 v1, v[4:7], s[14:15] offset:3072 sc0 sc1
    global_store_dwordx4 v2, v[4:7], s[14:15] sc0 sc1
    global_store_dwordx4 v2, v[4:7], s[14:15] offset:1024 sc0 sc1
    v_mul_u32_u24 v2, 4352, v22
    v_add_u32 v2, 0x80000, v2
    v_mov_b32 v8, 0
    s_mov_b64 exec, 0xff
    global_store_dword v2, v8, s[14:15] sc0 sc1
    global_store_dword v2, v8, s[14:15] offset:2048 sc0 sc1
    s_mov_b64 exec, -1
L_noinit:
    s_bitcmp1_b32 s36, 0
    s_cselect_b32 s24, s25, s26
    buffer_load_dwordx4 v[42:45], v90, s[16:19], s24 offen nt
    s_bitcmp1_b32 s36, 1
    s_cselect_b32 s24, s25, s26
    s_xor_b32 s24, s24, 65536
    buffer_load_dwordx4 v[46:49], v90, s[16:19], s24 offen nt
    s_cmp_lg_u32 s28, 0
    s_cbranch_scc1 L_npw
    s_getreg_b32 s55, hwreg(HW_REG_XCC_ID, 0, 3)
    s_lshr_b32 s34, s55, 2
    s_bitcmp1_b32 s30, 2
    s_cselect_b32 s3, s20, s16
    s_add_u32 s35, s35, s3
    s_lshr_b32 s3, s35, 13
    s_xor_b32 s34, s34, s3
    s_lshr_b32 s3, s35, 21
    s_xor_b32 s34, s34, s3
    s_waitcnt lgkmcnt(0)
    s_sub_u32 s56, s56, s58
    s_lshr_b32 s56, s56, 4
    s_min_u32 s56, s56, 15
    s_bitcmp0_b32 s34, 0
    s_cselect_b32 s3, 15, 0
    s_xor_b32 s56, s56, s3
    s_cmp_ge_u32 s30, 4
    s_cbranch_scc1 L_nev
    s_lshl_b32 s3, s55, 20
    s_cmp_eq_u32 s2, 0
    s_cselect_b32 s3, s3, 0
    s_lshl_b32 s34, s56, 8
    s_or_b32 s3, s3, s34
    s_or_b32 s3, s3, 1
    v_mov_b32 v2, 0
    v_mov_b32 v8, s3
    s_mov_b64 exec, 1
    global_atomic_add v2, v8, s[12:13] offset:64 sc1
    s_mov_b64 exec, -1
L_nev:
    s_lshl_b32 s55, s55, 4
    s_or_b32 s56, s56, s55
L_npw:
    s_lshl_b32 s3, s2, 4
    s_add_u32 s3, s3, s28
    s_cmp_lg_u32 s3, 1
    s_cbranch_scc1 L_nif
    v_mov_b32 v2, 0
    v_mov_b32 v8, 1
    s_waitcnt vmcnt(2)
    s_mov_b64 exec, 1
    global_store_dword v2, v8, s[12:13] offset:192 sc0 sc1
    s_mov_b64 exec, -1
L_nif:
    s_barrier
    s_cmp_lg_u32 s28, 3
    s_cbranch_scc1 L_ncpf
    s_getpc_b64 s[58:59]
L_pc:
    s_and_b32 s3, s30, 15
    s_lshl_b32 s3, s3, 10
    s_min_u32 s3, s3, L_end-L_pc-1024
    s_add_u32 s58, s58, s3
    s_addc_u32 s59, s59, 0
    s_and_b32 s58, s58, -16
    v_mov_b32 v13, s59
    v_add_co_u32 v12, vcc, s58, v1
    s_nop 1
    v_addc_co_u32 v13, vcc, 0, v13, vcc
    global_load_dwordx4 v[12:15], v[12:13], off
L_ncpf:
    s_bitcmp1_b32 s36, 2
    s_cselect_b32 s24, s25, s26
    s_xor_b32 s24, s24, 2048
    buffer_load_dwordx4 v[50:53], v90, s[16:19], s24 offen nt
    s_mov_b32 s33, 0x3f803f80
    s_mov_b32 s42, 0xffff0000
    s_mov_b32 s40, 0x7fffff80
    s_mov_b32 s41, 64
    v_lshrrev_b32 v3, 4, v0
    v_lshlrev_b32 v3, 3, v3
    v_lshlrev_b32 v22, 3, v22
    v_mov_b32 v23, v22
    v_and_b32 v8, 1, v0
    v_lshlrev_b32 v8, 4, v8
    v_mov_b32 v9, 0xffff
    v_lshlrev_b32 v9, v8, v9
    v_and_b32 v8, 2, v0
    v_cmp_eq_u32 vcc, 0, v8
    s_mov_b32 s62, 0
    s_mov_b32 s43, 0
    v_cndmask_b32 v40, 0, v9, vcc
    v_cndmask_b32 v41, v9, 0, vcc
    v_and_b32 v24, s33, v40
    v_and_b32 v25, s33, v41
    s_mov_b32 s63, 0x3fffffff
    s_and_b32 s61, s2, 7
    s_mul_i32 s61, s61, 4352
    s_add_u32 s61, s61, 0x80000
    s_mov_b32 s31, 13
    s_mov_b32 s67, 0
    s_mov_b32 s66, 0
    s_xor_b32 s3, s26, 0
    s_add_u32 s3, s3, s16
    s_lshr_b32 s34, s3, 8
    s_xor_b32 s3, s3, s34
    s_bitcmp1_b32 s3, 13
    s_cselect_b32 s3, 5, 0
    s_or_b32 s67, s67, s3
    s_xor_b32 s3, s26, 0
    s_add_u32 s3, s3, s20
    s_lshr_b32 s34, s3, 8
    s_xor_b32 s3, s3, s34
    s_bitcmp1_b32 s3, 13
    s_cselect_b32 s3, 5, 0
    s_or_b32 s66, s66, s3
    s_xor_b32 s3, s26, 65536
    s_add_u32 s3, s3, s16
    s_lshr_b32 s34, s3, 8
    s_xor_b32 s3, s3, s34
    s_bitcmp1_b32 s3, 13
    s_cselect_b32 s3, 10, 0
    s_or_b32 s67, s67, s3
    s_xor_b32 s3, s26, 65536
    s_add_u32 s3, s3, s20
    s_lshr_b32 s34, s3, 8
    s_xor_b32 s3, s3, s34
    s_bitcmp1_b32 s3, 13
    s_cselect_b32 s3, 10, 0
    s_or_b32 s66, s66, s3
    s_waitcnt vmcnt(2)
    v_dot2_f32_bf16 v16, v42, s33, 0
    v_dot2_f32_bf16 v18, v42, v42, 0
    v_dot2_f32_bf16 v17, v43, s33, 0
    v_dot2_f32_bf16 v19, v43, v43, 0
    v_dot2_f32_bf16 v16, v44, s33, v16
    v_dot2_f32_bf16 v18, v44, v44, v18
    v_dot2_f32_bf16 v17, v45, s33, v17
    v_dot2_f32_bf16 v19, v45, v45, v19
    s_barrier
    s_cmp_lg_u32 s28, 0
    s_cbranch_scc1 L_naf
    v_mov_b32 v2, 0
    global_load_dword v20, v2, s[12:13] offset:192 sc0 sc1
L_naf:
    s_bitcmp1_b32 s36, 3
    s_cselect_b32 s24, s25, s26
    s_xor_b32 s24, s24, 67584
    buffer_load_dwordx4 v[54:57], v90, s[16:19], s24 offen nt
    s_waitcnt vmcnt(2)
    v_dot2_f32_bf16 v16, v46, s33, v16
    v_dot2_f32_bf16 v18, v46, v46, v18
    v_dot2_f32_bf16 v17, v47, s33, v17
    v_dot2_f32_bf16 v19, v47, v47, v19
    v_dot2_f32_bf16 v16, v48, s33, v16
    v_dot2_f32_bf16 v18, v48, v48, v18
    v_dot2_f32_bf16 v17, v49, s33, v17
    v_dot2_f32_bf16 v19, v49, v49, v19
    s_barrier
    s_add_u32 s26, s26, 16777216
    s_add_u32 s25, s25, 16777216
    s_add_u32 s36, s36, 16777216
    s_andn2_b32 s36, s36, 31
    s_or_b32 s36, s36, s39
    s_mov_b32 s51, s36
    s_bitcmp1_b32 s36, 0
    s_cselect_b32 s24, s25, s26
    buffer_load_dwordx4 v[58:61], v90, s[16:19], s24 offen nt
    s_waitcnt vmcnt(2)
    v_dot2_f32_bf16 v16, v50, s33, v16
    v_dot2_f32_bf16 v18, v50, v50, v18
    v_dot2_f32_bf16 v17, v51, s33, v17
    v_dot2_f32_bf16 v19, v51, v51, v19
    v_dot2_f32_bf16 v16, v52, s33, v16
    v_dot2_f32_bf16 v18, v52, v52, v18
    v_dot2_f32_bf16 v17, v53, s33, v17
    v_dot2_f32_bf16 v19, v53, v53, v19
    s_waitcnt vmcnt(1)
    v_dot2_f32_bf16 v16, v54, s33, v16
    v_dot2_f32_bf16 v18, v54, v54, v18
    v_dot2_f32_bf16 v17, v55, s33, v17
    v_dot2_f32_bf16 v19, v55, v55, v19
    v_dot2_f32_bf16 v16, v56, s33, v16
    v_dot2_f32_bf16 v18, v56, v56, v18
    v_dot2_f32_bf16 v17, v57, s33, v17
    v_dot2_f32_bf16 v19, v57, v57, v19
    s_cmp_lg_u32 s28, 0
    s_cbranch_scc1 L_df
    v_mov_b32 v2, 0
    s_mov_b32 s35, 0
L_wf:
    v_cmp_eq_u32 vcc, 0, v20
    s_add_u32 s35, s35, 1
    s_cbranch_vccz L_df
    s_cmp_ge_u32 s35, 65536
    s_cbranch_scc1 L_df
    s_sleep 1
    global_load_dword v20, v2, s[12:13] offset:192 sc0 sc1
    s_waitcnt vmcnt(0)
    s_branch L_wf
L_df:
    s_mov_b32 s71, 0
    s_call_b64 s[72:73], F_rows
    s_barrier
    s_cmp_lg_u32 s28, 0
    s_cbranch_scc1 L_nmq1
    s_mov_b32 s70, s50
    s_mov_b32 s71, 0
    s_call_b64 s[72:73], F_merge
L_nmq1:
    s_cmp_eq_u32 s28, 0
    s_cselect_b32 s40, 0x7fffffff, s40
    s_mov_b32 s41, 0
    s_mov_b32 s56, 0
    s_bitcmp1_b32 s36, 1
    s_cselect_b32 s24, s25, s26
    s_xor_b32 s24, s24, 65536
    buffer_load_dwordx4 v[62:65], v90, s[16:19], s24 offen nt
    s_waitcnt vmcnt(2)
    s_barrier
    s_bitcmp1_b32 s36, 2
    s_cselect_b32 s24, s25, s26
    s_xor_b32 s24, s24, 2048
    buffer_load_dwordx4 v[66:69], v90, s[16:19], s24 offen nt
    s_waitcnt vmcnt(2)
    v_dot2_f32_bf16 v16, v58, s33, 0
    v_dot2_f32_bf16 v18, v58, v58, 0
    v_dot2_f32_bf16 v17, v59, s33, 0
    v_dot2_f32_bf16 v19, v59, v59, 0
    v_dot2_f32_bf16 v16, v60, s33, v16
    v_dot2_f32_bf16 v18, v60, v60, v18
    v_dot2_f32_bf16 v17, v61, s33, v17
    v_dot2_f32_bf16 v19, v61, v61, v19
    s_barrier
    s_cmp_lg_u32 s28, 1
    s_cbranch_scc1 L_nae
    v_mov_b32 v2, 0
    global_load_dword v20, v2, s[12:13] offset:64 sc0 sc1
L_nae:
    s_bitcmp1_b32 s36, 3
    s_cselect_b32 s24, s25, s26
    s_xor_b32 s24, s24, 67584
    buffer_load_dwordx4 v[70:73], v90, s[16:19], s24 offen nt
    s_waitcnt vmcnt(2)
    v_dot2_f32_bf16 v16, v62, s33, v16
    v_dot2_f32_bf16 v18, v62, v62, v18
    v_dot2_f32_bf16 v17, v63, s33, v17
    v_dot2_f32_bf16 v19, v63, v63, v19
    v_dot2_f32_bf16 v16, v64, s33, v16
    v_dot2_f32_bf16 v18, v64, v64, v18
    v_dot2_f32_bf16 v17, v65, s33, v17
    v_dot2_f32_bf16 v19, v65, v65, v19
    s_barrier
    s_add_u32 s26, s26, 16777216
    s_add_u32 s25, s25, 16777216
    s_add_u32 s36, s36, 16777216
    s_andn2_b32 s36, s36, 31
    s_or_b32 s36, s36, s39
    s_mov_b32 s52, s36
    s_bitcmp1_b32 s36, 0
    s_cselect_b32 s24, s25, s26
    buffer_load_dwordx4 v[74:77], v90, s[16:19], s24 offen nt
    s_waitcnt vmcnt(2)
    v_dot2_f32_bf16 v16, v66, s33, v16
    v_dot2_f32_bf16 v18, v66, v66, v18
    v_dot2_f32_bf16 v17, v67, s33, v17
    v_dot2_f32_bf16 v19, v67, v67, v19
    v_dot2_f32_bf16 v16, v68, s33, v16
    v_dot2_f32_bf16 v18, v68, v68, v18
    v_dot2_f32_bf16 v17, v69, s33, v17
    v_dot2_f32_bf16 v19, v69, v69, v19
    s_cmp_lg_u32 s28, 1
    s_cbranch_scc1 L_nec
    v_mov_b32 v2, 0
    s_mov_b32 s35, 0
L_we:
    v_and_b32 v8, 0xff, v20
    v_cmp_gt_u32 vcc, 32, v8
    s_add_u32 s35, s35, 1
    s_cbranch_vccz L_de
    s_cmp_ge_u32 s35, 65536
    s_cbranch_scc1 L_de
    s_sleep 8
    global_load_dword v20, v2, s[12:13] offset:64 sc0 sc1
    s_waitcnt vmcnt(0)
    s_branch L_we
L_de:
    v_mov_b32 v2, 1640
    ds_write_b32 v2, v20
    s_waitcnt lgkmcnt(0)
L_nec:
    s_barrier
    v_mov_b32 v2, 1640
    ds_read_b32 v8, v2
    s_waitcnt lgkmcnt(0)
    v_readfirstlane_b32 s60, v8
    s_nop 3
    s_bfe_u32 s34, s60, 0xa0008
    s_lshr_b32 s3, s60, 20
    s_add_u32 s3, s3, s2
    s_bitcmp1_b32 s3, 2
    s_cselect_b32 s3, 15, 0
    s_cmp_ge_u32 s34, 240
    s_cselect_b32 s35, 15, 0
    s_xor_b32 s3, s3, s35
    s_xor_b32 s3, s3, s67
    s_and_b32 s35, s39, 15
    s_sub_u32 s34, s34, 191
    s_cmp_lt_u32 s34, 99
    s_cselect_b32 s3, s35, s3
    s_andn2_b32 s39, s39, 15
    s_or_b32 s39, s39, s3
    s_and_b32 s3, s3, 14
    s_andn2_b32 s36, s36, 14
    s_or_b32 s36, s36, s3
    s_mov_b32 s52, s36
    s_cmp_lg_u32 s28, 1
    s_cbranch_scc1 L_npp
    s_mov_b32 s46, s50
    s_lshr_b32 s3, s46, 22
    s_lshl_b32 s3, s3, 9
    v_add_u32 v23, s3, v22
    global_load_dwordx2 v[20:21], v23, s[14:15] sc0 sc1
    s_lshr_b32 s3, s46, 16
    s_and_b32 s3, s3, 0x7fc
    s_load_dword s44, s[4:5], s3
    s_load_dword s45, s[6:7], s3
L_npp:
    s_bitcmp1_b32 s36, 1
    s_cselect_b32 s24, s25, s26
    s_xor_b32 s24, s24, 65536
    buffer_load_dwordx4 v[78:81], v90, s[16:19], s24 offen nt
    s_waitcnt vmcnt(2)
    v_dot2_f32_bf16 v16, v70, s33, v16
    v_dot2_f32_bf16 v18, v70, v70, v18
    v_dot2_f32_bf16 v17, v71, s33, v17
    v_dot2_f32_bf16 v19, v71, v71, v19
    v_dot2_f32_bf16 v16, v72, s33, v16
    v_dot2_f32_bf16 v18, v72, v72, v18
    v_dot2_f32_bf16 v17, v73, s33, v17
    v_dot2_f32_bf16 v19, v73, v73, v19
    s_mov_b32 s71, 512
    s_call_b64 s[72:73], F_rows
    s_barrier
    s_cmp_lg_u32 s28, 0
    s_cbranch_scc1 L_nmq2
    s_mov_b32 s70, s51
    s_mov_b32 s71, 512
    s_call_b64 s[72:73], F_merge
L_nmq2:
    s_bitcmp1_b32 s36, 2
    s_cselect_b32 s24, s25, s26
    s_xor_b32 s24, s24, 2048
    buffer_load_dwordx4 v[82:85], v90, s[16:19], s24 offen nt
    s_waitcnt vmcnt(2)
    v_dot2_f32_bf16 v16, v74, s33, 0
    v_dot2_f32_bf16 v18, v74, v74, 0
    v_dot2_f32_bf16 v17, v75, s33, 0
    v_dot2_f32_bf16 v19, v75, v75, 0
    v_dot2_f32_bf16 v16, v76, s33, v16
    v_dot2_f32_bf16 v18, v76, v76, v18
    v_dot2_f32_bf16 v17, v77, s33, v17
    v_dot2_f32_bf16 v19, v77, v77, v19
    s_cmp_lg_u32 s28, 1
    s_cbranch_scc1 L_nocfg
    s_mov_b32 s35, 0
L_wv:
    v_lshrrev_b32 v12, 31, v21
    v_or_b32 v12, v12, v20
    v_and_b32 v12, 1, v12
    v_cmp_ne_u32 vcc, 0, v12
    s_add_u32 s35, s35, 1
    s_cbranch_vccz L_dv
    s_cmp_ge_u32 s35, 65536
    s_cbranch_scc1 L_dv
    s_sleep 8
    global_load_dwordx2 v[20:21], v23, s[14:15] sc0 sc1
    s_waitcnt vmcnt(0)
    s_branch L_wv
L_dv:
    v_readlane_b32 s34, v21, 0
    v_and_b32 v8, 15, v21
    v_and_b32 v9, 8, v0
    v_lshlrev_b32 v9, 1, v9
    v_lshlrev_b32 v8, v9, v8
    s_nop 1
    v_add_u32_dpp v8, v8, v8 row_ror:1 row_mask:0xf bank_mask:0xf
    s_nop 1
    v_add_u32_dpp v8, v8, v8 row_ror:2 row_mask:0xf bank_mask:0xf
    s_nop 1
    v_add_u32_dpp v8, v8, v8 row_ror:4 row_mask:0xf bank_mask:0xf
    s_nop 1
    v_add_u32_dpp v8, v8, v8 row_ror:8 row_mask:0xf bank_mask:0xf
    s_nop 0
    v_readlane_b32 s56, v8, 0
    v_readlane_b32 s57, v8, 16
    v_readlane_b32 s58, v8, 32
    v_readlane_b32 s59, v8, 48
    s_lshr_b32 s34, s34, 4
    s_and_b32 s34, s34, 4
    s_nop 1
    s_add_u32 s56, s56, s57
    s_add_u32 s58, s58, s59
    s_add_u32 s56, s56, s58
    s_and_b32 s57, s56, 0xffff
    s_lshr_b32 s58, s56, 16
    s_cmp_ge_u32 s57, 280
    s_cselect_b32 s59, 8, 0
    s_or_b32 s34, s34, s59
    s_sub_u32 s57, s57, 201
    s_cmp_lt_u32 s57, 79
    s_cselect_b32 s59, 32, 0
    s_or_b32 s34, s34, s59
    s_cmp_ge_u32 s58, 280
    s_cselect_b32 s59, 64, 0
    s_or_b32 s34, s34, s59
    s_sub_u32 s58, s58, 201
    s_cmp_lt_u32 s58, 79
    s_cselect_b32 s59, 0x80, 0
    s_or_b32 s34, s34, s59
    v_mov_b32 v8, s34
    v_mov_b32 v2, 1632
    ds_write_b32 v2, v8
    s_mov_b32 s71, 1536
    s_call_b64 s[72:73], F_check
    s_mov_b32 s40, 0x7fffffff
L_nocfg:
    s_barrier
    v_mov_b32 v2, 1632
    ds_read_b32 v8, v2
    v_mov_b32 v2, 1536
    ds_read_b128 v[32:35], v2
    ds_read_b128 v[4:7], v2 offset:16
    s_bitcmp1_b32 s36, 3
    s_cselect_b32 s24, s25, s26
    s_xor_b32 s24, s24, 67584
    buffer_load_dwordx4 v[86:89], v90, s[16:19], s24 offen nt
    s_waitcnt lgkmcnt(0)
    v_readfirstlane_b32 s60, v8
    s_nop 3
    s_add_u32 s3, s2, s60
    s_lshr_b32 s3, s3, 2
    s_lshr_b32 s34, s60, 3
    s_xor_b32 s3, s3, s34
    s_bitcmp1_b32 s3, 0
    s_cselect_b32 s3, 0x1f, 0
    s_xor_b32 s3, s3, s67
    s_bitcmp1_b32 s60, 5
    s_cselect_b32 s39, s39, s3
    s_xor_b32 s34, s34, s60
    s_bitcmp1_b32 s34, 3
    s_cselect_b32 s54, 15, 0
    s_xor_b32 s54, s54, s67
    s_xor_b32 s54, s54, s66
    s_bfe_u32 s34, s30, 0x20000
    s_lshr_b32 s34, 17, s34
    s_and_b32 s54, s54, s34
    s_and_b32 s3, s60, 0xa0
    s_cselect_b32 s54, 0, s54
    s_waitcnt vmcnt(2)
    v_dot2_f32_bf16 v16, v78, s33, v16
    v_dot2_f32_bf16 v18, v78, v78, v18
    v_dot2_f32_bf16 v17, v79, s33, v17
    v_dot2_f32_bf16 v19, v79, v79, v19
    v_dot2_f32_bf16 v16, v80, s33, v16
    v_dot2_f32_bf16 v18, v80, v80, v18
    v_dot2_f32_bf16 v17, v81, s33, v17
    v_dot2_f32_bf16 v19, v81, v81, v19
    s_barrier
L_loop:
    s_mov_b32 s37, s50
    s_sub_u32 s27, s26, 33554432
    s_or_b32 s38, s27, 0x2000
    s_add_u32 s26, s26, 16777216
    s_add_u32 s25, s25, 16777216
    s_and_b32 s36, s26, 0xfffe0000
    s_or_b32 s36, s36, s39
    s_cmp_le_i32 s31, 3
    s_cselect_b32 s3, s54, 0
    s_xor_b32 s36, s36, s3
    s_mov_b32 s50, s36
    s_waitcnt lgkmcnt(0)
    s_cmp_lg_u32 s28, 15
    s_cbranch_scc1 L_nrl0_0
    s_cmp_lt_i32 s31, 1
    s_cbranch_scc1 L_nrl0_0
    s_mov_b32 s63, 1
    s_atomic_add s63, s[14:15], s61 glc
L_nrl0_0:
    v_mfma_f32_4x4x4_16b_bf16 v[8:11], v[24:25], v[42:43], v[32:35]
    v_mfma_f32_4x4x4_16b_bf16 v[12:15], v[24:25], v[44:45], v[32:35]
    s_nop 3
    v_pk_fma_f32 v[8:9], v[8:9], v[4:5], v[6:7]
    v_pk_fma_f32 v[10:11], v[10:11], v[4:5], v[6:7]
    v_pk_fma_f32 v[12:13], v[12:13], v[4:5], v[6:7]
    v_pk_fma_f32 v[14:15], v[14:15], v[4:5], v[6:7]
    v_cvt_pk_bf16_f32 v42, v8, v9
    v_cvt_pk_bf16_f32 v43, v10, v11
    v_cvt_pk_bf16_f32 v44, v12, v13
    v_cvt_pk_bf16_f32 v45, v14, v15
    s_bitcmp1_b32 s37, 0
    s_cselect_b32 s24, s38, s27
    buffer_store_dwordx4 v[42:45], v90, s[20:23], s24 offen sc0 sc1
    s_cmp_lt_i32 s31, 1
    s_cbranch_scc1 L_el0_0
    s_bitcmp1_b32 s36, 0
    s_cselect_b32 s24, s25, s26
    s_barrier
    buffer_load_dwordx4 v[42:45], v90, s[16:19], s24 offen nt
    s_waitcnt vmcnt(3)
    v_dot2_f32_bf16 v16, v82, s33, v16
    v_dot2_f32_bf16 v18, v82, v82, v18
    v_dot2_f32_bf16 v17, v83, s33, v17
    v_dot2_f32_bf16 v19, v83, v83, v19
    v_dot2_f32_bf16 v16, v84, s33, v16
    v_dot2_f32_bf16 v18, v84, v84, v18
    v_dot2_f32_bf16 v17, v85, s33, v17
    v_dot2_f32_bf16 v19, v85, v85, v19
    s_branch L_fl0_0
L_el0_0:
    s_barrier
L_fl0_0:
    v_mfma_f32_4x4x4_16b_bf16 v[8:11], v[24:25], v[46:47], v[32:35]
    v_mfma_f32_4x4x4_16b_bf16 v[12:15], v[24:25], v[48:49], v[32:35]
    s_nop 3
    v_pk_fma_f32 v[8:9], v[8:9], v[4:5], v[6:7]
    v_pk_fma_f32 v[10:11], v[10:11], v[4:5], v[6:7]
    v_pk_fma_f32 v[12:13], v[12:13], v[4:5], v[6:7]
    v_pk_fma_f32 v[14:15], v[14:15], v[4:5], v[6:7]
    v_cvt_pk_bf16_f32 v46, v8, v9
    v_cvt_pk_bf16_f32 v47, v10, v11
    v_cvt_pk_bf16_f32 v48, v12, v13
    v_cvt_pk_bf16_f32 v49, v14, v15
    s_bitcmp1_b32 s37, 1
    s_cselect_b32 s24, s38, s27
    s_xor_b32 s24, s24, 65536
    buffer_store_dwordx4 v[46:49], v90, s[20:23], s24 offen sc0 sc1
    s_cmp_lt_i32 s31, 1
    s_cbranch_scc1 L_el0_1
    s_bitcmp1_b32 s36, 1
    s_cselect_b32 s24, s25, s26
    s_xor_b32 s24, s24, 65536
    s_barrier
    buffer_load_dwordx4 v[46:49], v90, s[16:19], s24 offen nt
    s_waitcnt vmcnt(4)
    v_dot2_f32_bf16 v16, v86, s33, v16
    v_dot2_f32_bf16 v18, v86, v86, v18
    v_dot2_f32_bf16 v17, v87, s33, v17
    v_dot2_f32_bf16 v19, v87, v87, v19
    v_dot2_f32_bf16 v16, v88, s33, v16
    v_dot2_f32_bf16 v18, v88, v88, v18
    v_dot2_f32_bf16 v17, v89, s33, v17
    v_dot2_f32_bf16 v19, v89, v89, v19
    s_mov_b32 s71, 1024
    s_call_b64 s[72:73], F_rows
    s_barrier
    s_cmp_lg_u32 s28, 0
    s_cbranch_scc1 L_nmq3
    s_mov_b32 s70, s52
    s_mov_b32 s71, 1024
    s_call_b64 s[72:73], F_merge
L_nmq3:
    s_branch L_fl0_1
L_el0_1:
    s_barrier
L_fl0_1:
    s_cmp_lg_u32 s28, 1
    s_cbranch_scc1 L_npl0_2
    s_cmp_lt_i32 s31, 1
    s_cbranch_scc1 L_npl0_2
    s_mov_b32 s46, s51
    s_lshr_b32 s3, s46, 22
    s_lshl_b32 s3, s3, 9
    v_add_u32 v23, s3, v22
    global_load_dwordx2 v[20:21], v23, s[14:15] sc0 sc1
    s_lshr_b32 s3, s46, 16
    s_and_b32 s3, s3, 0x7fc
    s_load_dword s44, s[4:5], s3
    s_load_dword s45, s[6:7], s3
L_npl0_2:
    s_sub_u32 s64, s63, s62
    s_add_u32 s62, s62, 32
    v_mfma_f32_4x4x4_16b_bf16 v[8:11], v[24:25], v[50:51], v[32:35]
    v_mfma_f32_4x4x4_16b_bf16 v[12:15], v[24:25], v[52:53], v[32:35]
    s_nop 3
    v_pk_fma_f32 v[8:9], v[8:9], v[4:5], v[6:7]
    v_pk_fma_f32 v[10:11], v[10:11], v[4:5], v[6:7]
    v_pk_fma_f32 v[12:13], v[12:13], v[4:5], v[6:7]
    v_pk_fma_f32 v[14:15], v[14:15], v[4:5], v[6:7]
    v_cvt_pk_bf16_f32 v50, v8, v9
    v_cvt_pk_bf16_f32 v51, v10, v11
    v_cvt_pk_bf16_f32 v52, v12, v13
    v_cvt_pk_bf16_f32 v53, v14, v15
    s_bitcmp1_b32 s37, 2
    s_cselect_b32 s24, s38, s27
    s_xor_b32 s24, s24, 2048
    buffer_store_dwordx4 v[50:53], v90, s[20:23], s24 offen sc0 sc1
    s_cmp_lt_i32 s31, 1
    s_cbranch_scc1 L_el0_2
    s_bitcmp1_b32 s36, 2
    s_cselect_b32 s24, s25, s26
    s_xor_b32 s24, s24, 2048
    s_barrier
    buffer_load_dwordx4 v[50:53], v90, s[16:19], s24 offen nt
    s_cmp_ge_i32 s64, 11
    s_cbranch_scc1 L_nthl0_2
    s_waitcnt vmcnt(0)
L_nthl0_2:
    s_waitcnt vmcnt(4)
    v_dot2_f32_bf16 v16, v42, s33, 0
    v_dot2_f32_bf16 v18, v42, v42, 0
    v_dot2_f32_bf16 v17, v43, s33, 0
    v_dot2_f32_bf16 v19, v43, v43, 0
    v_dot2_f32_bf16 v16, v44, s33, v16
    v_dot2_f32_bf16 v18, v44, v44, v18
    v_dot2_f32_bf16 v17, v45, s33, v17
    v_dot2_f32_bf16 v19, v45, v45, v19
    s_branch L_fl0_2
L_el0_2:
    s_barrier
L_fl0_2:
    s_cmp_lg_u32 s31, 1
    s_cbranch_scc1 L_nsg
    s_cmp_lg_u32 s28, 3
    s_cbranch_scc1 L_nsg
    s_mov_b32 s43, 1
    s_add_u32 s3, s61, 2048
    s_atomic_add s43, s[14:15], s3 glc
L_nsg:
    v_mfma_f32_4x4x4_16b_bf16 v[8:11], v[24:25], v[54:55], v[32:35]
    v_mfma_f32_4x4x4_16b_bf16 v[12:15], v[24:25], v[56:57], v[32:35]
    s_nop 3
    v_pk_fma_f32 v[8:9], v[8:9], v[4:5], v[6:7]
    v_pk_fma_f32 v[10:11], v[10:11], v[4:5], v[6:7]
    v_pk_fma_f32 v[12:13], v[12:13], v[4:5], v[6:7]
    v_pk_fma_f32 v[14:15], v[14:15], v[4:5], v[6:7]
    v_cvt_pk_bf16_f32 v54, v8, v9
    v_cvt_pk_bf16_f32 v55, v10, v11
    v_cvt_pk_bf16_f32 v56, v12, v13
    v_cvt_pk_bf16_f32 v57, v14, v15
    s_bitcmp1_b32 s37, 3
    s_cselect_b32 s24, s38, s27
    s_xor_b32 s24, s24, 67584
    buffer_store_dwordx4 v[54:57], v90, s[20:23], s24 offen sc0 sc1
    s_cmp_lt_i32 s31, 1
    s_cbranch_scc1 L_el0_3
    s_bitcmp1_b32 s36, 3
    s_cselect_b32 s24, s25, s26
    s_xor_b32 s24, s24, 67584
    s_barrier
    buffer_load_dwordx4 v[54:57], v90, s[16:19], s24 offen nt
    s_cmp_lg_u32 s31, 1
    s_cbranch_scc1 L_nop
    s_waitcnt lgkmcnt(0)
    s_cmp_lg_u32 s43, 31
    s_cbranch_scc1 L_nop
    s_mov_b32 s43, 1
    s_atomic_add s43, s[12:13], 160
L_nop:
    s_waitcnt vmcnt(4)
    v_dot2_f32_bf16 v16, v46, s33, v16
    v_dot2_f32_bf16 v18, v46, v46, v18
    v_dot2_f32_bf16 v17, v47, s33, v17
    v_dot2_f32_bf16 v19, v47, v47, v19
    v_dot2_f32_bf16 v16, v48, s33, v16
    v_dot2_f32_bf16 v18, v48, v48, v18
    v_dot2_f32_bf16 v17, v49, s33, v17
    v_dot2_f32_bf16 v19, v49, v49, v19
    s_cmp_lg_u32 s28, 1
    s_cbranch_scc1 L_ncl0_3
    s_mov_b32 s71, 1568
    s_call_b64 s[72:73], F_check
L_ncl0_3:
    s_barrier
    v_mov_b32 v2, 1568
    ds_read_b128 v[32:35], v2
    ds_read_b128 v[4:7], v2 offset:16
    s_branch L_fl0_3
L_el0_3:
    s_endpgm
L_fl0_3:
    s_sub_u32 s31, s31, 1
    s_mov_b32 s37, s51
    s_sub_u32 s27, s26, 33554432
    s_or_b32 s38, s27, 0x2000
    s_add_u32 s26, s26, 16777216
    s_add_u32 s25, s25, 16777216
    s_and_b32 s36, s26, 0xfffe0000
    s_or_b32 s36, s36, s39
    s_cmp_le_i32 s31, 3
    s_cselect_b32 s3, s54, 0
    s_xor_b32 s36, s36, s3
    s_mov_b32 s51, s36
    s_waitcnt lgkmcnt(0)
    s_cmp_lg_u32 s28, 15
    s_cbranch_scc1 L_nrl1_0
    s_cmp_lt_i32 s31, 1
    s_cbranch_scc1 L_nrl1_0
    s_mov_b32 s63, 1
    s_atomic_add s63, s[14:15], s61 glc
L_nrl1_0:
    v_mfma_f32_4x4x4_16b_bf16 v[8:11], v[24:25], v[58:59], v[32:35]
    v_mfma_f32_4x4x4_16b_bf16 v[12:15], v[24:25], v[60:61], v[32:35]
    s_nop 3
    v_pk_fma_f32 v[8:9], v[8:9], v[4:5], v[6:7]
    v_pk_fma_f32 v[10:11], v[10:11], v[4:5], v[6:7]
    v_pk_fma_f32 v[12:13], v[12:13], v[4:5], v[6:7]
    v_pk_fma_f32 v[14:15], v[14:15], v[4:5], v[6:7]
    v_cvt_pk_bf16_f32 v58, v8, v9
    v_cvt_pk_bf16_f32 v59, v10, v11
    v_cvt_pk_bf16_f32 v60, v12, v13
    v_cvt_pk_bf16_f32 v61, v14, v15
    s_cmp_lg_u32 s31, 0
    s_cbranch_scc1 L_ng
    s_waitcnt vmcnt(2)
    v_dot2_f32_bf16 v16, v50, s33, v16
    v_dot2_f32_bf16 v18, v50, v50, v18
    v_dot2_f32_bf16 v17, v51, s33, v17
    v_dot2_f32_bf16 v19, v51, v51, v19
    v_dot2_f32_bf16 v16, v52, s33, v16
    v_dot2_f32_bf16 v18, v52, v52, v18
    v_dot2_f32_bf16 v17, v53, s33, v17
    v_dot2_f32_bf16 v19, v53, v53, v19
    s_waitcnt vmcnt(0)
    v_dot2_f32_bf16 v16, v54, s33, v16
    v_dot2_f32_bf16 v18, v54, v54, v18
    v_dot2_f32_bf16 v17, v55, s33, v17
    v_dot2_f32_bf16 v19, v55, v55, v19
    v_dot2_f32_bf16 v16, v56, s33, v16
    v_dot2_f32_bf16 v18, v56, v56, v18
    v_dot2_f32_bf16 v17, v57, s33, v17
    v_dot2_f32_bf16 v19, v57, v57, v19
    s_mov_b32 s71, 0
    s_call_b64 s[72:73], F_rows
    s_barrier
    s_cmp_lg_u32 s28, 0
    s_cbranch_scc1 L_nmq4
    s_mov_b32 s70, s50
    s_mov_b32 s71, 0
    s_call_b64 s[72:73], F_merge
L_nmq4:
    s_cmp_lg_u32 s28, 1
    s_cbranch_scc1 L_dg
    v_mov_b32 v2, 0
    global_load_dword v8, v2, s[12:13] offset:160 sc0 sc1
    s_waitcnt vmcnt(0)
    s_mov_b32 s35, 0
L_wg:
    v_cmp_gt_u32 vcc, 8, v8
    s_add_u32 s35, s35, 1
    s_cbranch_vccz L_dg
    s_cmp_ge_u32 s35, 65536
    s_cbranch_scc1 L_dg
    s_sleep 1
    global_load_dword v8, v2, s[12:13] offset:160 sc0 sc1
    s_waitcnt vmcnt(0)
    s_branch L_wg
L_dg:
    s_barrier
    s_cmp_lg_u32 s28, 1
    s_cbranch_scc1 L_npl1_0y
    s_mov_b32 s46, s52
    s_lshr_b32 s3, s46, 22
    s_lshl_b32 s3, s3, 9
    v_add_u32 v23, s3, v22
    global_load_dwordx2 v[20:21], v23, s[14:15] sc0 sc1
    s_lshr_b32 s3, s46, 16
    s_and_b32 s3, s3, 0x7fc
    s_load_dword s44, s[4:5], s3
    s_load_dword s45, s[6:7], s3
L_npl1_0y:
L_ng:
    s_bitcmp1_b32 s37, 0
    s_cselect_b32 s24, s38, s27
    buffer_store_dwordx4 v[58:61], v90, s[20:23], s24 offen sc0 sc1
    s_cmp_lt_i32 s31, 1
    s_cbranch_scc1 L_el1_0
    s_bitcmp1_b32 s36, 0
    s_cselect_b32 s24, s25, s26
    s_barrier
    buffer_load_dwordx4 v[58:61], v90, s[16:19], s24 offen nt
    s_waitcnt vmcnt(4)
    v_dot2_f32_bf16 v16, v50, s33, v16
    v_dot2_f32_bf16 v18, v50, v50, v18
    v_dot2_f32_bf16 v17, v51, s33, v17
    v_dot2_f32_bf16 v19, v51, v51, v19
    v_dot2_f32_bf16 v16, v52, s33, v16
    v_dot2_f32_bf16 v18, v52, v52, v18
    v_dot2_f32_bf16 v17, v53, s33, v17
    v_dot2_f32_bf16 v19, v53, v53, v19
    s_branch L_fl1_0
L_el1_0:
    s_barrier
L_fl1_0:
    v_mfma_f32_4x4x4_16b_bf16 v[8:11], v[24:25], v[62:63], v[32:35]
    v_mfma_f32_4x4x4_16b_bf16 v[12:15], v[24:25], v[64:65], v[32:35]
    s_nop 3
    v_pk_fma_f32 v[8:9], v[8:9], v[4:5], v[6:7]
    v_pk_fma_f32 v[10:11], v[10:11], v[4:5], v[6:7]
    v_pk_fma_f32 v[12:13], v[12:13], v[4:5], v[6:7]
    v_pk_fma_f32 v[14:15], v[14:15], v[4:5], v[6:7]
    v_cvt_pk_bf16_f32 v62, v8, v9
    v_cvt_pk_bf16_f32 v63, v10, v11
    v_cvt_pk_bf16_f32 v64, v12, v13
    v_cvt_pk_bf16_f32 v65, v14, v15
    s_bitcmp1_b32 s37, 1
    s_cselect_b32 s24, s38, s27
    s_xor_b32 s24, s24, 65536
    buffer_store_dwordx4 v[62:65], v90, s[20:23], s24 offen sc0 sc1
    s_cmp_lt_i32 s31, 1
    s_cbranch_scc1 L_el1_1
    s_bitcmp1_b32 s36, 1
    s_cselect_b32 s24, s25, s26
    s_xor_b32 s24, s24, 65536
    s_barrier
    buffer_load_dwordx4 v[62:65], v90, s[16:19], s24 offen nt
    s_waitcnt vmcnt(4)
    v_dot2_f32_bf16 v16, v54, s33, v16
    v_dot2_f32_bf16 v18, v54, v54, v18
    v_dot2_f32_bf16 v17, v55, s33, v17
    v_dot2_f32_bf16 v19, v55, v55, v19
    v_dot2_f32_bf16 v16, v56, s33, v16
    v_dot2_f32_bf16 v18, v56, v56, v18
    v_dot2_f32_bf16 v17, v57, s33, v17
    v_dot2_f32_bf16 v19, v57, v57, v19
    s_mov_b32 s71, 0
    s_call_b64 s[72:73], F_rows
    s_barrier
    s_cmp_lg_u32 s28, 0
    s_cbranch_scc1 L_nmq5
    s_mov_b32 s70, s50
    s_mov_b32 s71, 0
    s_call_b64 s[72:73], F_merge
L_nmq5:
    s_branch L_fl1_1
L_el1_1:
    s_barrier
    s_cmp_lg_u32 s28, 1
    s_cbranch_scc1 L_ncl1_1y
    s_cmp_lg_i32 s31, 0
    s_cbranch_scc1 L_ncl1_1y
    s_waitcnt vmcnt(2)
    s_mov_b32 s71, 1600
    s_call_b64 s[72:73], F_check
L_ncl1_1y:
L_fl1_1:
    s_cmp_lg_u32 s28, 1
    s_cbranch_scc1 L_npl1_2
    s_cmp_lt_i32 s31, 1
    s_cbranch_scc1 L_npl1_2
    s_mov_b32 s46, s52
    s_lshr_b32 s3, s46, 22
    s_lshl_b32 s3, s3, 9
    v_add_u32 v23, s3, v22
    global_load_dwordx2 v[20:21], v23, s[14:15] sc0 sc1
    s_lshr_b32 s3, s46, 16
    s_and_b32 s3, s3, 0x7fc
    s_load_dword s44, s[4:5], s3
    s_load_dword s45, s[6:7], s3
L_npl1_2:
    s_sub_u32 s64, s63, s62
    s_add_u32 s62, s62, 32
    v_mfma_f32_4x4x4_16b_bf16 v[8:11], v[24:25], v[66:67], v[32:35]
    v_mfma_f32_4x4x4_16b_bf16 v[12:15], v[24:25], v[68:69], v[32:35]
    s_nop 3
    v_pk_fma_f32 v[8:9], v[8:9], v[4:5], v[6:7]
    v_pk_fma_f32 v[10:11], v[10:11], v[4:5], v[6:7]
    v_pk_fma_f32 v[12:13], v[12:13], v[4:5], v[6:7]
    v_pk_fma_f32 v[14:15], v[14:15], v[4:5], v[6:7]
    v_cvt_pk_bf16_f32 v66, v8, v9
    v_cvt_pk_bf16_f32 v67, v10, v11
    v_cvt_pk_bf16_f32 v68, v12, v13
    v_cvt_pk_bf16_f32 v69, v14, v15
    s_bitcmp1_b32 s37, 2
    s_cselect_b32 s24, s38, s27
    s_xor_b32 s24, s24, 2048
    buffer_store_dwordx4 v[66:69], v90, s[20:23], s24 offen sc0 sc1
    s_cmp_lt_i32 s31, 1
    s_cbranch_scc1 L_el1_2
    s_bitcmp1_b32 s36, 2
    s_cselect_b32 s24, s25, s26
    s_xor_b32 s24, s24, 2048
    s_barrier
    buffer_load_dwordx4 v[66:69], v90, s[16:19], s24 offen nt
    s_cmp_ge_i32 s64, 11
    s_cbranch_scc1 L_nthl1_2
    s_waitcnt vmcnt(0)
L_nthl1_2:
    s_waitcnt vmcnt(4)
    v_dot2_f32_bf16 v16, v58, s33, 0
    v_dot2_f32_bf16 v18, v58, v58, 0
    v_dot2_f32_bf16 v17, v59, s33, 0
    v_dot2_f32_bf16 v19, v59, v59, 0
    v_dot2_f32_bf16 v16, v60, s33, v16
    v_dot2_f32_bf16 v18, v60, v60, v18
    v_dot2_f32_bf16 v17, v61, s33, v17
    v_dot2_f32_bf16 v19, v61, v61, v19
    s_branch L_fl1_2
L_el1_2:
    s_barrier
L_fl1_2:
    s_cmp_lg_u32 s28, 1
    s_cbranch_scc1 L_npl1_3x
    s_cmp_lg_i32 s31, 0
    s_cbranch_scc1 L_npl1_3x
    s_mov_b32 s46, s50
    s_lshr_b32 s3, s46, 22
    s_lshl_b32 s3, s3, 9
    v_add_u32 v23, s3, v22
    global_load_dwordx2 v[20:21], v23, s[14:15] sc0 sc1
    s_lshr_b32 s3, s46, 16
    s_and_b32 s3, s3, 0x7fc
    s_load_dword s44, s[4:5], s3
    s_load_dword s45, s[6:7], s3
L_npl1_3x:
    v_mfma_f32_4x4x4_16b_bf16 v[8:11], v[24:25], v[70:71], v[32:35]
    v_mfma_f32_4x4x4_16b_bf16 v[12:15], v[24:25], v[72:73], v[32:35]
    s_nop 3
    v_pk_fma_f32 v[8:9], v[8:9], v[4:5], v[6:7]
    v_pk_fma_f32 v[10:11], v[10:11], v[4:5], v[6:7]
    v_pk_fma_f32 v[12:13], v[12:13], v[4:5], v[6:7]
    v_pk_fma_f32 v[14:15], v[14:15], v[4:5], v[6:7]
    v_cvt_pk_bf16_f32 v70, v8, v9
    v_cvt_pk_bf16_f32 v71, v10, v11
    v_cvt_pk_bf16_f32 v72, v12, v13
    v_cvt_pk_bf16_f32 v73, v14, v15
    s_bitcmp1_b32 s37, 3
    s_cselect_b32 s24, s38, s27
    s_xor_b32 s24, s24, 67584
    buffer_store_dwordx4 v[70:73], v90, s[20:23], s24 offen sc0 sc1
    s_cmp_lt_i32 s31, 1
    s_cbranch_scc1 L_el1_3
    s_bitcmp1_b32 s36, 3
    s_cselect_b32 s24, s25, s26
    s_xor_b32 s24, s24, 67584
    s_barrier
    buffer_load_dwordx4 v[70:73], v90, s[16:19], s24 offen nt
    s_waitcnt vmcnt(4)
    v_dot2_f32_bf16 v16, v62, s33, v16
    v_dot2_f32_bf16 v18, v62, v62, v18
    v_dot2_f32_bf16 v17, v63, s33, v17
    v_dot2_f32_bf16 v19, v63, v63, v19
    v_dot2_f32_bf16 v16, v64, s33, v16
    v_dot2_f32_bf16 v18, v64, v64, v18
    v_dot2_f32_bf16 v17, v65, s33, v17
    v_dot2_f32_bf16 v19, v65, v65, v19
    s_cmp_lg_u32 s28, 1
    s_cbranch_scc1 L_ncl1_3
    s_mov_b32 s71, 1600
    s_call_b64 s[72:73], F_check
L_ncl1_3:
    s_barrier
    v_mov_b32 v2, 1600
    ds_read_b128 v[32:35], v2
    ds_read_b128 v[4:7], v2 offset:16
    s_branch L_fl1_3
L_el1_3:
    s_barrier
    v_mov_b32 v2, 1600
    ds_read_b128 v[32:35], v2
    ds_read_b128 v[4:7], v2 offset:16
L_fl1_3:
    s_sub_u32 s31, s31, 1
    s_mov_b32 s37, s52
    s_sub_u32 s27, s26, 33554432
    s_or_b32 s38, s27, 0x2000
    s_add_u32 s26, s26, 16777216
    s_add_u32 s25, s25, 16777216
    s_and_b32 s36, s26, 0xfffe0000
    s_or_b32 s36, s36, s39
    s_cmp_le_i32 s31, 3
    s_cselect_b32 s3, s54, 0
    s_xor_b32 s36, s36, s3
    s_mov_b32 s52, s36
    s_waitcnt lgkmcnt(0)
    s_cmp_lg_u32 s28, 15
    s_cbranch_scc1 L_nrl2_0
    s_cmp_lt_i32 s31, 1
    s_cbranch_scc1 L_nrl2_0
    s_mov_b32 s63, 1
    s_atomic_add s63, s[14:15], s61 glc
L_nrl2_0:
    v_mfma_f32_4x4x4_16b_bf16 v[8:11], v[24:25], v[74:75], v[32:35]
    v_mfma_f32_4x4x4_16b_bf16 v[12:15], v[24:25], v[76:77], v[32:35]
    s_nop 3
    v_pk_fma_f32 v[8:9], v[8:9], v[4:5], v[6:7]
    v_pk_fma_f32 v[10:11], v[10:11], v[4:5], v[6:7]
    v_pk_fma_f32 v[12:13], v[12:13], v[4:5], v[6:7]
    v_pk_fma_f32 v[14:15], v[14:15], v[4:5], v[6:7]
    v_cvt_pk_bf16_f32 v74, v8, v9
    v_cvt_pk_bf16_f32 v75, v10, v11
    v_cvt_pk_bf16_f32 v76, v12, v13
    v_cvt_pk_bf16_f32 v77, v14, v15
    s_bitcmp1_b32 s37, 0
    s_cselect_b32 s24, s38, s27
    buffer_store_dwordx4 v[74:77], v90, s[20:23], s24 offen sc0 sc1
    s_cmp_lt_i32 s31, 1
    s_cbranch_scc1 L_el2_0
    s_bitcmp1_b32 s36, 0
    s_cselect_b32 s24, s25, s26
    s_barrier
    buffer_load_dwordx4 v[74:77], v90, s[16:19], s24 offen nt
    s_waitcnt vmcnt(4)
    v_dot2_f32_bf16 v16, v66, s33, v16
    v_dot2_f32_bf16 v18, v66, v66, v18
    v_dot2_f32_bf16 v17, v67, s33, v17
    v_dot2_f32_bf16 v19, v67, v67, v19
    v_dot2_f32_bf16 v16, v68, s33, v16
    v_dot2_f32_bf16 v18, v68, v68, v18
    v_dot2_f32_bf16 v17, v69, s33, v17
    v_dot2_f32_bf16 v19, v69, v69, v19
    s_branch L_fl2_0
L_el2_0:
    s_barrier
    s_cmp_lg_u32 s28, 1
    s_cbranch_scc1 L_ncl2_0x
    s_cmp_lg_i32 s31, -1
    s_cbranch_scc1 L_ncl2_0x
    s_waitcnt vmcnt(2)
    s_mov_b32 s71, 1536
    s_call_b64 s[72:73], F_check
L_ncl2_0x:
L_fl2_0:
    v_mfma_f32_4x4x4_16b_bf16 v[8:11], v[24:25], v[78:79], v[32:35]
    v_mfma_f32_4x4x4_16b_bf16 v[12:15], v[24:25], v[80:81], v[32:35]
    s_nop 3
    v_pk_fma_f32 v[8:9], v[8:9], v[4:5], v[6:7]
    v_pk_fma_f32 v[10:11], v[10:11], v[4:5], v[6:7]
    v_pk_fma_f32 v[12:13], v[12:13], v[4:5], v[6:7]
    v_pk_fma_f32 v[14:15], v[14:15], v[4:5], v[6:7]
    v_cvt_pk_bf16_f32 v78, v8, v9
    v_cvt_pk_bf16_f32 v79, v10, v11
    v_cvt_pk_bf16_f32 v80, v12, v13
    v_cvt_pk_bf16_f32 v81, v14, v15
    s_bitcmp1_b32 s37, 1
    s_cselect_b32 s24, s38, s27
    s_xor_b32 s24, s24, 65536
    buffer_store_dwordx4 v[78:81], v90, s[20:23], s24 offen sc0 sc1
    s_cmp_lt_i32 s31, 1
    s_cbranch_scc1 L_el2_1
    s_bitcmp1_b32 s36, 1
    s_cselect_b32 s24, s25, s26
    s_xor_b32 s24, s24, 65536
    s_barrier
    buffer_load_dwordx4 v[78:81], v90, s[16:19], s24 offen nt
    s_waitcnt vmcnt(4)
    v_dot2_f32_bf16 v16, v70, s33, v16
    v_dot2_f32_bf16 v18, v70, v70, v18
    v_dot2_f32_bf16 v17, v71, s33, v17
    v_dot2_f32_bf16 v19, v71, v71, v19
    v_dot2_f32_bf16 v16, v72, s33, v16
    v_dot2_f32_bf16 v18, v72, v72, v18
    v_dot2_f32_bf16 v17, v73, s33, v17
    v_dot2_f32_bf16 v19, v73, v73, v19
    s_mov_b32 s71, 512
    s_call_b64 s[72:73], F_rows
    s_barrier
    s_cmp_lg_u32 s28, 0
    s_cbranch_scc1 L_nmq6
    s_mov_b32 s70, s51
    s_mov_b32 s71, 512
    s_call_b64 s[72:73], F_merge
L_nmq6:
    s_branch L_fl2_1
L_el2_1:
    s_barrier
L_fl2_1:
    s_cmp_lg_u32 s28, 1
    s_cbranch_scc1 L_npl2_2
    s_cmp_lt_i32 s31, 1
    s_cbranch_scc1 L_npl2_2
    s_mov_b32 s46, s50
    s_lshr_b32 s3, s46, 22
    s_lshl_b32 s3, s3, 9
    v_add_u32 v23, s3, v22
    global_load_dwordx2 v[20:21], v23, s[14:15] sc0 sc1
    s_lshr_b32 s3, s46, 16
    s_and_b32 s3, s3, 0x7fc
    s_load_dword s44, s[4:5], s3
    s_load_dword s45, s[6:7], s3
L_npl2_2:
    s_sub_u32 s64, s63, s62
    s_add_u32 s62, s62, 32
    v_mfma_f32_4x4x4_16b_bf16 v[8:11], v[24:25], v[82:83], v[32:35]
    v_mfma_f32_4x4x4_16b_bf16 v[12:15], v[24:25], v[84:85], v[32:35]
    s_nop 3
    v_pk_fma_f32 v[8:9], v[8:9], v[4:5], v[6:7]
    v_pk_fma_f32 v[10:11], v[10:11], v[4:5], v[6:7]
    v_pk_fma_f32 v[12:13], v[12:13], v[4:5], v[6:7]
    v_pk_fma_f32 v[14:15], v[14:15], v[4:5], v[6:7]
    v_cvt_pk_bf16_f32 v82, v8, v9
    v_cvt_pk_bf16_f32 v83, v10, v11
    v_cvt_pk_bf16_f32 v84, v12, v13
    v_cvt_pk_bf16_f32 v85, v14, v15
    s_bitcmp1_b32 s37, 2
    s_cselect_b32 s24, s38, s27
    s_xor_b32 s24, s24, 2048
    buffer_store_dwordx4 v[82:85], v90, s[20:23], s24 offen sc0 sc1
    s_cmp_lt_i32 s31, 1
    s_cbranch_scc1 L_el2_2
    s_bitcmp1_b32 s36, 2
    s_cselect_b32 s24, s25, s26
    s_xor_b32 s24, s24, 2048
    s_barrier
    buffer_load_dwordx4 v[82:85], v90, s[16:19], s24 offen nt
    s_cmp_ge_i32 s64, 11
    s_cbranch_scc1 L_nthl2_2
    s_waitcnt vmcnt(0)
L_nthl2_2:
    s_waitcnt vmcnt(4)
    v_dot2_f32_bf16 v16, v74, s33, 0
    v_dot2_f32_bf16 v18, v74, v74, 0
    v_dot2_f32_bf16 v17, v75, s33, 0
    v_dot2_f32_bf16 v19, v75, v75, 0
    v_dot2_f32_bf16 v16, v76, s33, v16
    v_dot2_f32_bf16 v18, v76, v76, v18
    v_dot2_f32_bf16 v17, v77, s33, v17
    v_dot2_f32_bf16 v19, v77, v77, v19
    s_branch L_fl2_2
L_el2_2:
    s_barrier
L_fl2_2:
    v_mfma_f32_4x4x4_16b_bf16 v[8:11], v[24:25], v[86:87], v[32:35]
    v_mfma_f32_4x4x4_16b_bf16 v[12:15], v[24:25], v[88:89], v[32:35]
    s_nop 3
    v_pk_fma_f32 v[8:9], v[8:9], v[4:5], v[6:7]
    v_pk_fma_f32 v[10:11], v[10:11], v[4:5], v[6:7]
    v_pk_fma_f32 v[12:13], v[12:13], v[4:5], v[6:7]
    v_pk_fma_f32 v[14:15], v[14:15], v[4:5], v[6:7]
    v_cvt_pk_bf16_f32 v86, v8, v9
    v_cvt_pk_bf16_f32 v87, v10, v11
    v_cvt_pk_bf16_f32 v88, v12, v13
    v_cvt_pk_bf16_f32 v89, v14, v15
    s_bitcmp1_b32 s37, 3
    s_cselect_b32 s24, s38, s27
    s_xor_b32 s24, s24, 67584
    buffer_store_dwordx4 v[86:89], v90, s[20:23], s24 offen sc0 sc1
    s_cmp_lt_i32 s31, 1
    s_cbranch_scc1 L_el2_3
    s_bitcmp1_b32 s36, 3
    s_cselect_b32 s24, s25, s26
    s_xor_b32 s24, s24, 67584
    s_barrier
    buffer_load_dwordx4 v[86:89], v90, s[16:19], s24 offen nt
    s_waitcnt vmcnt(4)
    v_dot2_f32_bf16 v16, v78, s33, v16
    v_dot2_f32_bf16 v18, v78, v78, v18
    v_dot2_f32_bf16 v17, v79, s33, v17
    v_dot2_f32_bf16 v19, v79, v79, v19
    v_dot2_f32_bf16 v16, v80, s33, v16
    v_dot2_f32_bf16 v18, v80, v80, v18
    v_dot2_f32_bf16 v17, v81, s33, v17
    v_dot2_f32_bf16 v19, v81, v81, v19
    s_cmp_lg_u32 s28, 1
    s_cbranch_scc1 L_ncl2_3
    s_mov_b32 s71, 1536
    s_call_b64 s[72:73], F_check
L_ncl2_3:
    s_barrier
    v_mov_b32 v2, 1536
    ds_read_b128 v[32:35], v2
    ds_read_b128 v[4:7], v2 offset:16
    s_branch L_fl2_3
L_el2_3:
    s_barrier
    v_mov_b32 v2, 1536
    ds_read_b128 v[32:35], v2
    ds_read_b128 v[4:7], v2 offset:16
L_fl2_3:
    s_sub_u32 s31, s31, 1
    s_branch L_loop
F_rows:
    s_nop 1
    v_add_f32 v8, v16, v17
    v_add_f32 v9, v18, v19
    v_mul_f32 v10, 0x3d000000, v8
    v_fma_f32 v9, -v8, v10, v9
    v_mov_b32 v8, v10
    s_nop 1
    v_add_f32_dpp v8, v8, v8 row_ror:8 row_mask:0xf bank_mask:0xf
    s_nop 1
    v_add_f32_dpp v8, v8, v8 row_ror:4 row_mask:0xf bank_mask:0xf
    s_nop 1
    v_add_f32_dpp v8, v8, v8 row_ror:2 row_mask:0xf bank_mask:0xf
    s_nop 1
    v_add_f32_dpp v8, v8, v8 row_ror:1 row_mask:0xf bank_mask:0xf
    v_mul_f32 v8, 0x3d800000, v8
    v_sub_f32 v10, v10, v8
    v_mul_f32 v11, 0x42000000, v10
    v_fmac_f32 v9, v11, v10
    s_nop 1
    v_add_f32_dpp v9, v9, v9 row_ror:8 row_mask:0xf bank_mask:0xf
    s_nop 1
    v_add_f32_dpp v9, v9, v9 row_ror:4 row_mask:0xf bank_mask:0xf
    s_nop 1
    v_add_f32_dpp v9, v9, v9 row_ror:2 row_mask:0xf bank_mask:0xf
    s_nop 1
    v_add_f32_dpp v9, v9, v9 row_ror:1 row_mask:0xf bank_mask:0xf
    v_add_u32 v2, s71, v3
    ds_write_b64 v2, v[8:9]
    s_waitcnt lgkmcnt(0)
    s_setpc_b64 s[72:73]
F_merge:
    v_add_u32 v2, s71, v22
    ds_read_b64 v[10:11], v2
    s_lshr_b32 s3, s70, 17
    s_lshl_b32 s3, s3, 4
    s_lshr_b32 s34, s70, 1
    s_and_b32 s34, s34, 8
    s_add_u32 s3, s3, s34
    v_mov_b32 v2, s3
    s_waitcnt lgkmcnt(0)
    v_mov_b32 v8, v10
    s_nop 1
    v_add_f32_dpp v8, v8, v8 row_ror:8 row_mask:0xf bank_mask:0xf
    s_nop 1
    v_add_f32_dpp v8, v8, v8 row_ror:4 row_mask:0xf bank_mask:0xf
    s_nop 1
    v_add_f32_dpp v8, v8, v8 row_ror:2 row_mask:0xf bank_mask:0xf
    s_nop 1
    v_add_f32_dpp v8, v8, v8 row_ror:1 row_mask:0xf bank_mask:0xf
    v_mov_b32 v9, v8
    s_nop 1
    v_permlane16_swap_b32 v8, v9
    s_nop 1
    v_add_f32 v8, v8, v9
    v_mov_b32 v9, v8
    s_nop 1
    v_permlane32_swap_b32 v8, v9
    s_nop 1
    v_add_f32 v8, v8, v9
    v_mul_f32 v8, 0x3c800000, v8
    v_sub_f32 v10, v10, v8
    v_mul_f32 v9, 0x44000000, v10
    v_fmac_f32 v11, v9, v10
    s_nop 1
    v_add_f32_dpp v11, v11, v11 row_ror:8 row_mask:0xf bank_mask:0xf
    s_nop 1
    v_add_f32_dpp v11, v11, v11 row_ror:4 row_mask:0xf bank_mask:0xf
    s_nop 1
    v_add_f32_dpp v11, v11, v11 row_ror:2 row_mask:0xf bank_mask:0xf
    s_nop 1
    v_add_f32_dpp v11, v11, v11 row_ror:1 row_mask:0xf bank_mask:0xf
    v_mov_b32 v9, v11
    s_nop 1
    v_permlane16_swap_b32 v11, v9
    s_nop 1
    v_add_f32 v11, v11, v9
    v_mov_b32 v9, v11
    s_nop 1
    v_permlane32_swap_b32 v11, v9
    s_nop 1
    v_add_f32 v11, v11, v9
    v_and_b32 v8, -2, v8
    v_add_u32 v11, s41, v11
    v_and_b32 v9, s40, v11
    v_or_b32 v9, s56, v9
    s_mov_b64 exec, 1
    global_store_dwordx2 v2, v[8:9], s[14:15] sc0 sc1
    s_mov_b64 exec, -1
    s_setpc_b64 s[72:73]
F_check:
    s_mov_b32 s35, 0
L_wc:
    v_lshrrev_b32 v12, 31, v21
    v_or_b32 v12, v12, v20
    v_and_b32 v12, 1, v12
    v_cmp_ne_u32 vcc, 0, v12
    s_add_u32 s35, s35, 1
    s_cbranch_vccz L_dc
    s_cmp_ge_u32 s35, 65536
    s_cbranch_scc1 L_dc
    s_sleep 4
    global_load_dwordx2 v[20:21], v23, s[14:15] sc0 sc1
    s_waitcnt vmcnt(0)
    s_branch L_wc
L_dc:
    v_mov_b32 v10, v20
    v_and_b32 v9, s40, v21
    v_mov_b32 v8, v10
    s_nop 1
    v_add_f32_dpp v8, v8, v8 row_ror:8 row_mask:0xf bank_mask:0xf
    s_nop 1
    v_add_f32_dpp v8, v8, v8 row_ror:4 row_mask:0xf bank_mask:0xf
    s_nop 1
    v_add_f32_dpp v8, v8, v8 row_ror:2 row_mask:0xf bank_mask:0xf
    s_nop 1
    v_add_f32_dpp v8, v8, v8 row_ror:1 row_mask:0xf bank_mask:0xf
    v_mov_b32 v11, v8
    s_nop 1
    v_permlane16_swap_b32 v8, v11
    s_nop 1
    v_add_f32 v8, v8, v11
    v_mov_b32 v11, v8
    s_nop 1
    v_permlane32_swap_b32 v8, v11
    s_nop 1
    v_add_f32 v8, v8, v11
    v_mul_f32 v8, 0x3c800000, v8
    v_sub_f32 v10, v10, v8
    v_mul_f32 v11, 0x47000000, v10
    v_fmac_f32 v9, v11, v10
    s_nop 1
    v_add_f32_dpp v9, v9, v9 row_ror:8 row_mask:0xf bank_mask:0xf
    s_nop 1
    v_add_f32_dpp v9, v9, v9 row_ror:4 row_mask:0xf bank_mask:0xf
    s_nop 1
    v_add_f32_dpp v9, v9, v9 row_ror:2 row_mask:0xf bank_mask:0xf
    s_nop 1
    v_add_f32_dpp v9, v9, v9 row_ror:1 row_mask:0xf bank_mask:0xf
    v_mov_b32 v11, v9
    s_nop 1
    v_permlane16_swap_b32 v9, v11
    s_nop 1
    v_add_f32 v9, v9, v11
    v_mov_b32 v11, v9
    s_nop 1
    v_permlane32_swap_b32 v9, v11
    s_nop 1
    v_add_f32 v9, v9, v11
    v_cvt_pk_bf16_f32 v10, v8, v8
    v_lshlrev_b32 v10, 16, v10
    v_sub_f32 v11, v8, v10
    v_mul_f32 v9, 0x35000000, v9
    v_fmac_f32 v9, v11, v11
    v_max_f32 v11, 0, v9
    v_cmp_u_f32 vcc, v9, v9
    s_nop 1
    v_cndmask_b32 v9, v11, v9, vcc
    v_mov_b32 v8, v10
    v_cvt_pk_bf16_f32 v9, v9, v9
    v_lshlrev_b32 v9, 16, v9
    v_add_f32 v9, 0x3727c5ac, v9
    v_cvt_pk_bf16_f32 v9, v9, v9
    v_lshlrev_b32 v9, 16, v9
    v_sqrt_f32 v9, v9
    s_nop 0
    v_cvt_pk_bf16_f32 v9, v9, v9
    v_lshlrev_b32 v9, 16, v9
    s_waitcnt lgkmcnt(0)
    v_rcp_f32 v9, v9
    s_bitcmp1_b32 s46, 17
    s_cselect_b32 s3, 0, 16
    s_lshl_b32 s44, s44, s3
    s_and_b32 s44, s44, 0xffff0000
    s_lshl_b32 s45, s45, s3
    s_and_b32 s45, s45, 0xffff0000
    v_mul_f32 v12, s44, v9
    v_mov_b32 v14, s45
    v_mov_b32 v15, s45
    v_mov_b32 v13, v12
    v_mov_b32 v2, s71
    v_xor_b32 v8, 0x80000000, v8
    v_mov_b32 v9, v8
    v_mov_b32 v10, v8
    v_mov_b32 v11, v8
    ds_write_b128 v2, v[12:15] offset:16
    v_mov_b32 v2, s71
    ds_write_b128 v2, v[8:11]
    s_waitcnt lgkmcnt(0)
    s_setpc_b64 s[72:73]
L_end:
    s_endpgm
.section .rodata,"a"
.p2align 6
.amdhsa_kernel standalone__groupnorm__prompt_kernel
  .amdhsa_next_free_vgpr 92
  .amdhsa_next_free_sgpr 74
  .amdhsa_accum_offset 92
  .amdhsa_group_segment_fixed_size 0
  .amdhsa_kernarg_size 48
  .amdhsa_user_sgpr_count 2
  .amdhsa_user_sgpr_kernarg_segment_ptr 1
  .amdhsa_system_sgpr_workgroup_id_x 1
  .amdhsa_float_denorm_mode_32 3
.end_amdhsa_kernel
```
